```python
import torch

def _softmax(x, axis=-1):
    return torch.softmax(x, dim=axis)
def _gelu(x):
    return torch.nn.functional.gelu(x, approximate="tanh")
def _silu(x):
    return torch.nn.functional.silu(x)
def _sigmoid(x):
    return torch.sigmoid(x)
def _layernorm(x, axis=-1, eps=1e-5):
    m = x.mean(dim=axis, keepdim=True)
    v = x.var(dim=axis, keepdim=True, unbiased=False)
    return (x - m) / torch.sqrt(v + eps)
def _scatter_add(tgt, idx, src, axis=0):
    return tgt.clone().index_add_(axis, idx, src)
def _segment_sum(src, seg, n):
    out = torch.zeros((n,) + src.shape[1:], dtype=src.dtype)
    return out.index_add_(0, seg, src)
def _pad(x, pw):
    flat = tuple(v for pair in reversed(pw) for v in pair)
    return torch.nn.functional.pad(x, flat)

kernel_name = 'standalone__sliding_block_cached__decode'

def setup_inputs():

    _w = (lambda a: (lambda t: t.to(torch.bfloat16) if t.is_floating_point() else t)(torch.as_tensor(a)))
    B, Sq, D = 4, 1, 512
    Hq, Hkv, Sk, Dh = 32, 8, 16384, 128
    assert Hq % Hkv == 0, (Hq, Hkv)
    return {
        "x": _w((lambda *s: torch.randn(*s, dtype=torch.bfloat16) * 0.8)(B, Sq, D)),
        "k_cache": _w((lambda *s: torch.randn(*s, dtype=torch.bfloat16) * 0.8)(B, Hkv, Sk, Dh)),
        "v_cache": _w((lambda *s: torch.randn(*s, dtype=torch.bfloat16) * 0.05)(B, Hkv, Sk, Dh)),
        "wq": _w((lambda *s: torch.randn(*s, dtype=torch.bfloat16) * 0.8)(D, Hq * Dh) * (D ** -0.5)),
        "wo": _w((lambda *s: torch.randn(*s, dtype=torch.bfloat16) * 0.05)(Hq * Dh, D) * ((Hq * Dh) ** -0.5)),
    }

def reference(x, k_cache, v_cache, wq, wo):
    B, Sq, D = x.shape
    Hq, Dh = 32, 128
    Hkv, Sk = k_cache.shape[1], k_cache.shape[2]
    W = min(4096, max(256, Sk // 4))
    rep = Hq // Hkv
    q = (lambda x, *d: x.permute(*d))((x @ wq).reshape(B, Sq, Hq, Dh), 0, 2, 1, 3)
    k = (lambda x, n, axis: torch.repeat_interleave(x, n, dim=axis))(k_cache[:, :, Sk - W:, :], rep, axis=1)
    v = (lambda x, n, axis: torch.repeat_interleave(x, n, dim=axis))(v_cache[:, :, Sk - W:, :], rep, axis=1)
    scores = torch.einsum("bhqd,bhkd->bhqk", q, k) * (Dh ** -0.5)
    p = _softmax(scores, axis=-1)
    o = torch.einsum("bhqk,bhkd->bhqd", p, v)
    return (lambda x, *d: x.permute(*d))(o, 0, 2, 1, 3).reshape(B, Sq, Hq * Dh) @ wo
```

```asm
; @launch grid=(256,1,1) block=(512,1,1) lds=43264
.amdgcn_target "amdgcn-amd-amdhsa--gfx950"
.text
.globl standalone__sliding_block_cached__decode_kernel
.p2align 8
.type standalone__sliding_block_cached__decode_kernel,@function
standalone__sliding_block_cached__decode_kernel:
    s_cmp_ge_u32 s2, 0x100
    s_cbranch_scc1 L_end
    s_load_dwordx16 s[8:23], s[0:1], 0
    v_lshrrev_b32 v3, 6, v0
    v_and_b32 v0, 63, v0
    v_readfirstlane_b32 s3, v3
    s_cmp_lg_u32 s3, 2
    s_cbranch_scc1 L_nopf
    s_getpc_b64 s[60:61]
L_pc:
    v_lshlrev_b32 v26, 6, v0
    v_min_u32 v26, L_end-L_pc, v26
    global_load_dword v26, v26, s[60:61]
    v_lshlrev_b32 v27, 6, v0
    v_add_u32 v27, 0x1000, v27
    v_min_u32 v27, L_end-L_pc, v27
    global_load_dword v27, v27, s[60:61]
L_nopf:
    s_and_b32 s4, s2, 7
    s_lshr_b32 s5, s2, 3
    s_lshr_b32 s6, s5, 3
    s_and_b32 s7, s5, 7
    v_lshlrev_b32 v2, 4, v0
    v_mov_b32 v30, 0
    v_mov_b32 v31, 1
    ds_write_b32 v2, v30 offset:42240
    v_and_b32 v1, 0x30, v2
    v_and_b32 v3, 12, v0
    v_lshl_or_b32 v1, v3, 6, v1
    v_and_b32 v3, 0x30, v0
    v_lshl_or_b32 v1, v3, 2, v1
    v_and_b32 v4, 0x70, v2
    v_and_b32 v5, 0x38, v0
    v_lshl_or_b32 v4, v5, 10, v4
    v_and_b32 v5, 12, v0
    v_lshl_or_b32 v5, v5, 8, v3
    s_lshl_b32 s47, s6, 3
    s_add_u32 s47, s47, s4
    s_lshl_b32 s47, s47, 22
    s_lshl_b32 s48, s7, 17
    s_add_u32 s47, s47, s48
    s_lshl_b32 s48, s3, 14
    s_add_u32 s47, s47, s48
    s_add_u32 s47, s47, 3145728
    s_lshl_b32 s58, s2, 3
    s_add_u32 s58, s58, s3
    s_mul_i32 s58, s58, 0x9E3779B1
    s_lshr_b32 s58, s58, 18
    s_and_b32 s58, s58, 0x3c00
    s_and_b32 s62, s5, 3
    s_lshr_b32 s63, s5, 2
    s_lshl_b32 s48, s62, 20
    s_lshl_b32 s49, s4, 10
    s_add_u32 s48, s48, s49
    s_lshl_b32 s49, s63, 7
    s_add_u32 s48, s48, s49
    s_lshl_b32 s49, s3, 17
    s_add_u32 s48, s48, s49
    s_lshl_b32 s50, s3, 11
    s_mov_b32 m0, s50
    s_lshl_b32 s49, s62, 8
    s_mov_b32 s26, 0x4000
    s_mov_b32 s27, 0x20000
    s_mov_b32 s30, 0x4000
    s_mov_b32 s31, 0x20000
    s_waitcnt lgkmcnt(0)
    s_load_dword s40, s[22:23], 0
    s_add_u32 s24, s10, s47
    s_addc_u32 s25, s11, 0
    s_xor_b32 s59, s58, 0
    buffer_load_dwordx4 v[64:67], v1, s[24:27], s59 offen nt
    s_add_u32 s32, s14, s48
    s_addc_u32 s33, s15, 0
    global_load_lds_dwordx4 v4, s[32:33] nt
    s_add_u32 s34, s32, 64512
    s_addc_u32 s35, s33, 0
    global_load_lds_dwordx4 v4, s[34:35] offset:1024 nt
    s_xor_b32 s59, s58, 1024
    buffer_load_dwordx4 v[68:71], v1, s[24:27], s59 offen nt
    s_barrier
    s_cmp_lg_u32 s3, 0
    s_cbranch_scc1 L_nox
    s_add_u32 s36, s8, s49
    s_addc_u32 s37, s9, 0
    v_and_b32 v6, 3, v0
    v_lshl_or_b32 v5, v6, 6, v5
    global_load_dwordx4 v[8:11], v5, s[36:37]
L_nox:
    s_xor_b32 s59, s58, 2048
    s_waitcnt vmcnt(4)
    buffer_load_dwordx4 v[72:75], v1, s[24:27], s59 offen nt
    s_xor_b32 s59, s58, 3072
    s_waitcnt vmcnt(4)
    buffer_load_dwordx4 v[76:79], v1, s[24:27], s59 offen nt
    s_xor_b32 s59, s58, 4096
    s_waitcnt vmcnt(4)
    buffer_load_dwordx4 v[80:83], v1, s[24:27], s59 offen nt
    s_waitcnt vmcnt(4)
    s_mov_b64 exec, 1
    ds_add_u32 v30, v31 offset:42240
    s_mov_b64 exec, -1
    s_xor_b32 s59, s58, 5120
    s_waitcnt vmcnt(4)
    buffer_load_dwordx4 v[84:87], v1, s[24:27], s59 offen nt
    s_add_u32 s28, s12, s47
    s_addc_u32 s29, s13, 0
    s_lshl_b32 s51, s4, 2
    s_add_u32 s51, s51, s6
    s_lshl_b32 s47, s51, 17
    s_lshr_b32 s48, s3, 1
    s_lshl_b32 s48, s48, 15
    s_add_u32 s47, s47, s48
    s_and_b32 s48, s3, 1
    s_lshl_b32 s48, s48, 12
    s_add_u32 s47, s47, s48
    s_lshl_b32 s48, s7, 7
    s_add_u32 s47, s47, s48
    s_add_u32 s38, s16, s47
    s_addc_u32 s39, s17, 0
    s_add_u32 s52, s38, 15360
    s_addc_u32 s53, s39, 0
    v_and_b32 v6, 32, v0
    v_lshlrev_b32 v6, 8, v6
    v_and_b32 v3, 0x18, v0
    v_lshl_or_b32 v6, v3, 7, v6
    v_and_b32 v3, 0x70, v2
    v_or_b32 v6, v6, v3
    v_and_b32 v7, 0xf0, v2
    v_and_b32 v3, 0x30, v0
    v_lshl_or_b32 v7, v3, 7, v7
    s_lshl_b32 s47, s4, 15
    s_lshl_b32 s48, s6, 13
    s_add_u32 s47, s47, s48
    s_lshl_b32 s48, s3, 8
    s_add_u32 s47, s47, s48
    s_add_u32 s47, s47, 1048576
    s_add_u32 s54, s22, s47
    s_addc_u32 s55, s23, 0
    s_lshl_b32 s47, s4, 15
    s_lshl_b32 s48, s62, 11
    s_add_u32 s47, s47, s48
    s_lshl_b32 s48, s63, 8
    s_add_u32 s47, s47, s48
    s_add_u32 s47, s47, 1048576
    s_add_u32 s36, s22, s47
    s_addc_u32 s37, s23, 0
    s_getreg_b32 s42, hwreg(HW_REG_XCC_ID, 0, 4)
    s_mov_b32 s57, 0xffffff00
    s_mov_b32 s44, 0x05040100
    s_mov_b32 s45, 0x07060302
    s_mov_b32 s46, 0x3e0293ee
    v_mov_b32 v32, 0
    v_mov_b32 v33, 0
    v_mov_b32 v34, 0
    v_mov_b32 v35, 0
    v_mov_b32 v36, 0
    v_mov_b32 v37, 0
    v_mov_b32 v38, 0
    v_mov_b32 v39, 0
    v_mov_b32 v40, 0
    v_mov_b32 v41, 0
    v_mov_b32 v42, 0
    v_mov_b32 v43, 0
    v_mov_b32 v44, 0
    v_mov_b32 v45, 0
    v_mov_b32 v46, 0
    v_mov_b32 v47, 0
    v_mov_b32 v48, 0
    v_mov_b32 v49, 0
    v_mov_b32 v50, 0
    v_mov_b32 v51, 0
    v_mov_b32 v52, 0
    v_mov_b32 v53, 0
    v_mov_b32 v54, 0
    v_mov_b32 v55, 0
    v_mov_b32 v56, 0
    v_mov_b32 v57, 0
    v_mov_b32 v58, 0
    v_mov_b32 v59, 0
    v_mov_b32 v60, 0
    v_mov_b32 v61, 0
    v_mov_b32 v62, 0
    v_mov_b32 v63, 0
    s_mov_b32 s56, 65536
    s_waitcnt lgkmcnt(0)
    s_add_u32 s43, s40, 1
    s_and_b32 s41, s43, 0xff
    s_and_b32 s47, s43, 0xf
    s_lshl_b32 s47, s47, 4
    s_or_b32 s42, s42, s47
    s_cmp_lg_u32 s3, 0
    s_cbranch_scc1 L_noq
    v_and_b32 v3, 3, v0
    v_lshlrev_b32 v3, 3, v3
    v_and_b32 v16, 12, v0
    v_lshl_or_b32 v3, v16, 5, v3
    v_and_b32 v16, 0x30, v0
    v_lshl_or_b32 v3, v16, 6, v3
L_w1:
    ds_read_b32 v16, v30 offset:42240
    s_sub_u32 s56, s56, 1
    s_cbranch_scc1 L_w1ok
    s_waitcnt lgkmcnt(0)
    v_cmp_ne_u32 vcc, 8, v16
    s_cbranch_vccnz L_w1
L_w1ok:
    ds_read_b64_tr_b16 v[192:193], v3 offset:0
    ds_read_b64_tr_b16 v[194:195], v3 offset:512
    ds_read_b64_tr_b16 v[196:197], v3 offset:32
    ds_read_b64_tr_b16 v[198:199], v3 offset:544
    ds_read_b64_tr_b16 v[200:201], v3 offset:64
    ds_read_b64_tr_b16 v[202:203], v3 offset:576
    ds_read_b64_tr_b16 v[204:205], v3 offset:96
    ds_read_b64_tr_b16 v[206:207], v3 offset:608
    ds_read_b64_tr_b16 v[208:209], v3 offset:4096
    ds_read_b64_tr_b16 v[210:211], v3 offset:4608
    ds_read_b64_tr_b16 v[212:213], v3 offset:4128
    ds_read_b64_tr_b16 v[214:215], v3 offset:4640
    ds_read_b64_tr_b16 v[216:217], v3 offset:4160
    ds_read_b64_tr_b16 v[218:219], v3 offset:4672
    ds_read_b64_tr_b16 v[220:221], v3 offset:4192
    ds_read_b64_tr_b16 v[222:223], v3 offset:4704
    ds_read_b64_tr_b16 v[224:225], v3 offset:8192
    ds_read_b64_tr_b16 v[226:227], v3 offset:8704
    ds_read_b64_tr_b16 v[228:229], v3 offset:8224
    ds_read_b64_tr_b16 v[230:231], v3 offset:8736
    ds_read_b64_tr_b16 v[232:233], v3 offset:8256
    ds_read_b64_tr_b16 v[234:235], v3 offset:8768
    ds_read_b64_tr_b16 v[236:237], v3 offset:8288
    ds_read_b64_tr_b16 v[238:239], v3 offset:8800
    ds_read_b64_tr_b16 v[240:241], v3 offset:12288
    ds_read_b64_tr_b16 v[242:243], v3 offset:12800
    ds_read_b64_tr_b16 v[244:245], v3 offset:12320
    ds_read_b64_tr_b16 v[246:247], v3 offset:12832
    ds_read_b64_tr_b16 v[248:249], v3 offset:12352
    ds_read_b64_tr_b16 v[250:251], v3 offset:12864
    ds_read_b64_tr_b16 v[252:253], v3 offset:12384
    ds_read_b64_tr_b16 v[254:255], v3 offset:12896
    s_waitcnt vmcnt(4)
    v_mov_b32_dpp v160, v8 quad_perm:[0,0,0,0] row_mask:0xf bank_mask:0xf
    v_mov_b32_dpp v161, v9 quad_perm:[0,0,0,0] row_mask:0xf bank_mask:0xf
    v_mov_b32_dpp v162, v10 quad_perm:[0,0,0,0] row_mask:0xf bank_mask:0xf
    v_mov_b32_dpp v163, v11 quad_perm:[0,0,0,0] row_mask:0xf bank_mask:0xf
    v_mov_b32_dpp v164, v8 quad_perm:[1,1,1,1] row_mask:0xf bank_mask:0xf
    v_mov_b32_dpp v165, v9 quad_perm:[1,1,1,1] row_mask:0xf bank_mask:0xf
    v_mov_b32_dpp v166, v10 quad_perm:[1,1,1,1] row_mask:0xf bank_mask:0xf
    v_mov_b32_dpp v167, v11 quad_perm:[1,1,1,1] row_mask:0xf bank_mask:0xf
    v_mov_b32_dpp v168, v8 quad_perm:[2,2,2,2] row_mask:0xf bank_mask:0xf
    v_mov_b32_dpp v169, v9 quad_perm:[2,2,2,2] row_mask:0xf bank_mask:0xf
    v_mov_b32_dpp v170, v10 quad_perm:[2,2,2,2] row_mask:0xf bank_mask:0xf
    v_mov_b32_dpp v171, v11 quad_perm:[2,2,2,2] row_mask:0xf bank_mask:0xf
    v_mov_b32_dpp v172, v8 quad_perm:[3,3,3,3] row_mask:0xf bank_mask:0xf
    v_mov_b32_dpp v173, v9 quad_perm:[3,3,3,3] row_mask:0xf bank_mask:0xf
    v_mov_b32_dpp v174, v10 quad_perm:[3,3,3,3] row_mask:0xf bank_mask:0xf
    v_mov_b32_dpp v175, v11 quad_perm:[3,3,3,3] row_mask:0xf bank_mask:0xf
    s_waitcnt lgkmcnt(15)
    v_mfma_f32_16x16x32_bf16 v[176:179], v[192:195], v[160:163], 0
    v_mfma_f32_16x16x32_bf16 v[180:183], v[196:199], v[160:163], 0
    v_mfma_f32_16x16x32_bf16 v[184:187], v[200:203], v[160:163], 0
    v_mfma_f32_16x16x32_bf16 v[188:191], v[204:207], v[160:163], 0
    s_waitcnt lgkmcnt(15)
    v_mfma_f32_16x16x32_bf16 v[176:179], v[208:211], v[164:167], v[176:179]
    v_mfma_f32_16x16x32_bf16 v[180:183], v[212:215], v[164:167], v[180:183]
    v_mfma_f32_16x16x32_bf16 v[184:187], v[216:219], v[164:167], v[184:187]
    v_mfma_f32_16x16x32_bf16 v[188:191], v[220:223], v[164:167], v[188:191]
    s_waitcnt lgkmcnt(8)
    v_mfma_f32_16x16x32_bf16 v[176:179], v[224:227], v[168:171], v[176:179]
    v_mfma_f32_16x16x32_bf16 v[180:183], v[228:231], v[168:171], v[180:183]
    v_mfma_f32_16x16x32_bf16 v[184:187], v[232:235], v[168:171], v[184:187]
    v_mfma_f32_16x16x32_bf16 v[188:191], v[236:239], v[168:171], v[188:191]
    s_waitcnt lgkmcnt(0)
    v_mfma_f32_16x16x32_bf16 v[176:179], v[240:243], v[172:175], v[176:179]
    v_mfma_f32_16x16x32_bf16 v[180:183], v[244:247], v[172:175], v[180:183]
    v_mfma_f32_16x16x32_bf16 v[184:187], v[248:251], v[172:175], v[184:187]
    v_mfma_f32_16x16x32_bf16 v[188:191], v[252:255], v[172:175], v[188:191]
    v_and_b32 v3, 12, v0
    v_lshlrev_b32 v3, 11, v3
    v_and_b32 v28, 0x30, v0
    v_or_b32 v3, v3, v28
    v_and_b32 v28, 3, v0
    v_lshl_or_b32 v3, v28, 6, v3
    v_mov_b32 v28, s42
    v_mov_b32 v29, s41
    s_nop 4
    s_mov_b32 vcc_lo, 0x22222222
    s_mov_b32 vcc_hi, 0x22222222
    v_cndmask_b32 v176, v176, v180, vcc
    v_cndmask_b32 v177, v177, v181, vcc
    v_cndmask_b32 v178, v178, v182, vcc
    v_cndmask_b32 v179, v179, v183, vcc
    s_mov_b32 vcc_lo, 0x44444444
    s_mov_b32 vcc_hi, 0x44444444
    v_cndmask_b32 v176, v176, v184, vcc
    v_cndmask_b32 v177, v177, v185, vcc
    v_cndmask_b32 v178, v178, v186, vcc
    v_cndmask_b32 v179, v179, v187, vcc
    s_mov_b32 vcc_lo, 0x88888888
    s_mov_b32 vcc_hi, 0x88888888
    v_cndmask_b32 v176, v176, v188, vcc
    v_cndmask_b32 v177, v177, v189, vcc
    v_cndmask_b32 v178, v178, v190, vcc
    v_cndmask_b32 v179, v179, v191, vcc
    v_and_or_b32 v24, v176, s57, v28
    v_and_or_b32 v25, v177, s57, v29
    v_and_or_b32 v26, v178, s57, v29
    v_and_or_b32 v27, v179, s57, v29
    global_store_dwordx4 v3, v[24:27], s[36:37]
    ds_write_b128 v2, v[24:27] offset:32768
    s_mov_b64 exec, 1
    ds_add_u32 v30, v31 offset:42288
    s_mov_b64 exec, -1
L_noq:
    s_xor_b32 s59, s58, 6144
    s_waitcnt vmcnt(4)
    buffer_load_dwordx4 v[88:91], v1, s[24:27], s59 offen nt
    v_and_b32 v3, 12, v0
    v_lshlrev_b32 v22, 5, v3
    v_lshrrev_b32 v21, 4, v0
    v_or_b32 v21, v21, v3
    v_mul_u32_u24 v21, 4096, v21
    v_and_b32 v3, 0x30, v0
    v_lshl_or_b32 v22, v3, 1, v22
    v_and_b32 v3, 0x30, v2
    v_or_b32 v21, v21, v3
    s_mul_i32 s47, s4, 65536
    s_lshl_b32 s48, s6, 6
    s_add_u32 s47, s47, s48
    s_lshl_b32 s48, s3, 8
    s_add_u32 s47, s47, s48
    s_add_u32 s47, s47, 1310720
    s_add_u32 s62, s22, s47
    s_addc_u32 s63, s23, 0
    s_lshl_b32 s47, s51, 9
    s_add_u32 s47, s47, 65536
    s_add_u32 s60, s22, s47
    s_addc_u32 s61, s23, 0
    s_lshl_b32 s47, s4, 5
    s_add_u32 s47, s47, s5
    s_mul_i32 s47, s47, 2048
    s_and_b32 s48, s3, 3
    s_lshl_b32 s48, s48, 9
    s_add_u32 s47, s47, s48
    s_lshr_b32 s48, s3, 2
    s_lshl_b32 s48, s48, 8
    s_add_u32 s47, s47, s48
    s_add_u32 s47, s47, 1310720
    s_add_u32 s32, s22, s47
    s_addc_u32 s33, s23, 0
    s_lshl_b32 s47, s4, 11
    s_lshl_b32 s48, s5, 4
    s_add_u32 s47, s47, s48
    s_add_u32 s47, s47, 65536
    s_add_u32 s34, s22, s47
    s_addc_u32 s35, s23, 0
    v_and_b32 v23, 3, v0
    v_and_b32 v3, 0x30, v0
    v_lshl_or_b32 v23, v23, 2, v3
    v_and_b32 v3, 12, v0
    v_lshl_or_b32 v23, v3, 4, v23
    v_add_u32 v19, s50, v2
    s_xor_b32 s59, s58, 7168
    s_waitcnt vmcnt(4)
    buffer_load_dwordx4 v[92:95], v1, s[24:27], s59 offen nt
    v_and_b32 v17, 15, v0
    v_lshlrev_b32 v17, 2, v17
    v_lshrrev_b32 v3, 4, v0
    v_or_b32 v17, v17, v3
    s_lshl_b32 s47, s3, 6
    v_or_b32 v17, s47, v17
    v_lshlrev_b32 v17, 1, v17
    v_and_b32 v18, 3, v0
    v_lshlrev_b32 v18, 8, v18
    v_and_b32 v3, 0x3c, v0
    v_lshl_or_b32 v18, v3, 2, v18
    s_xor_b32 s59, s58, 8192
    s_waitcnt vmcnt(4)
    buffer_load_dwordx4 v[96:99], v1, s[24:27], s59 offen nt
    s_xor_b32 s59, s58, 9216
    s_waitcnt vmcnt(4)
    buffer_load_dwordx4 v[100:103], v1, s[24:27], s59 offen nt
    s_xor_b32 s59, s58, 10240
    s_waitcnt vmcnt(3)
    buffer_load_dwordx4 v[104:107], v1, s[24:27], s59 offen nt
    s_xor_b32 s59, s58, 11264
    s_waitcnt vmcnt(3)
    buffer_load_dwordx4 v[108:111], v1, s[24:27], s59 offen nt
    s_xor_b32 s59, s58, 12288
    s_waitcnt vmcnt(3)
    buffer_load_dwordx4 v[112:115], v1, s[24:27], s59 offen nt
    global_load_dwordx4 v[8:11], v7, s[54:55] sc1 nt
    s_xor_b32 s59, s58, 13312
    s_waitcnt vmcnt(4)
    buffer_load_dwordx4 v[116:119], v1, s[24:27], s59 offen nt
    s_xor_b32 s59, s58, 14336
    s_waitcnt vmcnt(4)
    buffer_load_dwordx4 v[120:123], v1, s[24:27], s59 offen nt
    s_xor_b32 s59, s58, 15360
    s_waitcnt vmcnt(4)
    buffer_load_dwordx4 v[124:127], v1, s[24:27], s59 offen nt
    s_xor_b32 s59, s58, 0
    s_waitcnt vmcnt(4)
    buffer_load_dwordx4 v[128:131], v2, s[28:31], s59 offen nt
    s_waitcnt vmcnt(4)
    s_mov_b32 s56, 65536
L_qchk:
    v_xor_b32 v8, s42, v8
    v_xor_b32 v9, s41, v9
    v_xor_b32 v10, s41, v10
    v_xor_b32 v11, s41, v11
    v_and_b32 v12, 0xf0, v8
    v_or3_b32 v13, v9, v10, v11
    v_and_b32 v13, 0xff, v13
    v_or_b32 v13, v13, v12
    v_cmp_ne_u32 vcc, 0, v13
    s_cbranch_vccnz L_qretry
L_qok:
    v_and_b32 v12, 15, v8
    v_and_b32 v8, s57, v8
    v_cmp_ne_u32 vcc, 0, v12
    s_cmp_lg_u64 vcc, 0
    s_cselect_b32 s47, 0x101, 1
    v_permlane32_swap_b32 v8, v10
    v_permlane32_swap_b32 v9, v11
    v_add_f32 v8, v8, v10
    v_add_f32 v9, v9, v11
    v_mov_b32 v13, s47
    s_nop 0
    v_permlane16_swap_b32 v8, v9
    v_add_f32 v8, v8, v9
    v_cvt_pk_bf16_f32 v8, v8, v8
    ds_write_b16 v17, v8 offset:41216
    s_mov_b64 exec, 1
    ds_add_u32 v30, v13 offset:42256
    s_mov_b64 exec, -1
    v_and_b32 v3, 3, v0
    v_lshlrev_b32 v3, 6, v3
    s_lshl_b32 s47, s3, 3
    v_add_u32 v16, s47, v3
    s_xor_b32 s59, s58, 1024
    s_waitcnt vmcnt(3)
    buffer_load_dwordx4 v[132:135], v2, s[28:31], s59 offen nt
    s_xor_b32 s59, s58, 2048
    s_waitcnt vmcnt(3)
    buffer_load_dwordx4 v[136:139], v2, s[28:31], s59 offen nt
    s_xor_b32 s59, s58, 3072
    s_waitcnt vmcnt(3)
    buffer_load_dwordx4 v[140:143], v2, s[28:31], s59 offen nt
    s_mov_b32 s56, 65536
L_w2:
    ds_read_b32 v12, v30 offset:42256
    ds_read_b128 v[24:27], v18 offset:41216
    s_sub_u32 s56, s56, 1
    s_cbranch_scc1 L_w2ok
    s_waitcnt lgkmcnt(1)
    v_readfirstlane_b32 s42, v12
    s_and_b32 s47, s42, 0xff
    s_cmp_lg_u32 s47, 8
    s_cbranch_scc1 L_w2
L_w2ok:
    s_lshr_b32 s42, s42, 8
    s_cmp_lg_u32 s42, 0
    s_cbranch_scc1 L_rep2
L_rep2ret:
    s_waitcnt lgkmcnt(0)
    v_mfma_f32_16x16x32_bf16 v[192:195], v[64:67], v[24:27], 0
    v_mfma_f32_16x16x32_bf16 v[196:199], v[68:71], v[24:27], 0
    v_mfma_f32_16x16x32_bf16 v[200:203], v[72:75], v[24:27], 0
    v_mfma_f32_16x16x32_bf16 v[204:207], v[76:79], v[24:27], 0
    v_mfma_f32_16x16x32_bf16 v[208:211], v[80:83], v[24:27], 0
    v_mfma_f32_16x16x32_bf16 v[212:215], v[84:87], v[24:27], 0
    v_mfma_f32_16x16x32_bf16 v[216:219], v[88:91], v[24:27], 0
    v_mfma_f32_16x16x32_bf16 v[220:223], v[92:95], v[24:27], 0
    v_mfma_f32_16x16x32_bf16 v[224:227], v[96:99], v[24:27], 0
    v_mfma_f32_16x16x32_bf16 v[228:231], v[100:103], v[24:27], 0
    v_mfma_f32_16x16x32_bf16 v[232:235], v[104:107], v[24:27], 0
    v_mfma_f32_16x16x32_bf16 v[236:239], v[108:111], v[24:27], 0
    v_mfma_f32_16x16x32_bf16 v[240:243], v[112:115], v[24:27], 0
    v_mfma_f32_16x16x32_bf16 v[244:247], v[116:119], v[24:27], 0
    v_mfma_f32_16x16x32_bf16 v[248:251], v[120:123], v[24:27], 0
    v_mfma_f32_16x16x32_bf16 v[252:255], v[124:127], v[24:27], 0
    v_mov_b32 v17, 0
    v_mov_b32 v13, 1
    s_nop 1
    v_add_f32_dpp v28, v193, v192 row_ror:12 row_mask:0xf bank_mask:0x1
    v_add_f32_dpp v29, v197, v196 row_ror:12 row_mask:0xf bank_mask:0x1
    v_add_f32_dpp v30, v225, v224 row_ror:12 row_mask:0xf bank_mask:0x1
    v_add_f32_dpp v31, v229, v228 row_ror:12 row_mask:0xf bank_mask:0x1
    v_add_f32_dpp v28, v194, v28 row_ror:8 row_mask:0xf bank_mask:0x1
    v_add_f32_dpp v29, v198, v29 row_ror:8 row_mask:0xf bank_mask:0x1
    v_add_f32_dpp v30, v226, v30 row_ror:8 row_mask:0xf bank_mask:0x1
    v_add_f32_dpp v31, v230, v31 row_ror:8 row_mask:0xf bank_mask:0x1
    v_add_f32_dpp v28, v195, v28 row_ror:4 row_mask:0xf bank_mask:0x1
    v_add_f32_dpp v29, v199, v29 row_ror:4 row_mask:0xf bank_mask:0x1
    v_add_f32_dpp v30, v227, v30 row_ror:4 row_mask:0xf bank_mask:0x1
    v_add_f32_dpp v31, v231, v31 row_ror:4 row_mask:0xf bank_mask:0x1
    v_add_f32_dpp v28, v200, v201 row_ror:4 row_mask:0xf bank_mask:0x2
    v_add_f32_dpp v29, v204, v205 row_ror:4 row_mask:0xf bank_mask:0x2
    v_add_f32_dpp v30, v232, v233 row_ror:4 row_mask:0xf bank_mask:0x2
    v_add_f32_dpp v31, v236, v237 row_ror:4 row_mask:0xf bank_mask:0x2
    v_add_f32_dpp v28, v202, v28 row_ror:12 row_mask:0xf bank_mask:0x2
    v_add_f32_dpp v29, v206, v29 row_ror:12 row_mask:0xf bank_mask:0x2
    v_add_f32_dpp v30, v234, v30 row_ror:12 row_mask:0xf bank_mask:0x2
    v_add_f32_dpp v31, v238, v31 row_ror:12 row_mask:0xf bank_mask:0x2
    v_add_f32_dpp v28, v203, v28 row_ror:8 row_mask:0xf bank_mask:0x2
    v_add_f32_dpp v29, v207, v29 row_ror:8 row_mask:0xf bank_mask:0x2
    v_add_f32_dpp v30, v235, v30 row_ror:8 row_mask:0xf bank_mask:0x2
    v_add_f32_dpp v31, v239, v31 row_ror:8 row_mask:0xf bank_mask:0x2
    v_add_f32_dpp v28, v208, v210 row_ror:8 row_mask:0xf bank_mask:0x4
    v_add_f32_dpp v29, v212, v214 row_ror:8 row_mask:0xf bank_mask:0x4
    v_add_f32_dpp v30, v240, v242 row_ror:8 row_mask:0xf bank_mask:0x4
    v_add_f32_dpp v31, v244, v246 row_ror:8 row_mask:0xf bank_mask:0x4
    v_add_f32_dpp v28, v209, v28 row_ror:4 row_mask:0xf bank_mask:0x4
    v_add_f32_dpp v29, v213, v29 row_ror:4 row_mask:0xf bank_mask:0x4
    v_add_f32_dpp v30, v241, v30 row_ror:4 row_mask:0xf bank_mask:0x4
    v_add_f32_dpp v31, v245, v31 row_ror:4 row_mask:0xf bank_mask:0x4
    v_add_f32_dpp v28, v211, v28 row_ror:12 row_mask:0xf bank_mask:0x4
    v_add_f32_dpp v29, v215, v29 row_ror:12 row_mask:0xf bank_mask:0x4
    v_add_f32_dpp v30, v243, v30 row_ror:12 row_mask:0xf bank_mask:0x4
    v_add_f32_dpp v31, v247, v31 row_ror:12 row_mask:0xf bank_mask:0x4
    v_add_f32_dpp v28, v216, v219 row_ror:12 row_mask:0xf bank_mask:0x8
    v_add_f32_dpp v29, v220, v223 row_ror:12 row_mask:0xf bank_mask:0x8
    v_add_f32_dpp v30, v248, v251 row_ror:12 row_mask:0xf bank_mask:0x8
    v_add_f32_dpp v31, v252, v255 row_ror:12 row_mask:0xf bank_mask:0x8
    v_add_f32_dpp v28, v217, v28 row_ror:8 row_mask:0xf bank_mask:0x8
    v_add_f32_dpp v29, v221, v29 row_ror:8 row_mask:0xf bank_mask:0x8
    v_add_f32_dpp v30, v249, v30 row_ror:8 row_mask:0xf bank_mask:0x8
    v_add_f32_dpp v31, v253, v31 row_ror:8 row_mask:0xf bank_mask:0x8
    v_add_f32_dpp v28, v218, v28 row_ror:4 row_mask:0xf bank_mask:0x8
    v_add_f32_dpp v29, v222, v29 row_ror:4 row_mask:0xf bank_mask:0x8
    v_add_f32_dpp v30, v250, v30 row_ror:4 row_mask:0xf bank_mask:0x8
    v_add_f32_dpp v31, v254, v31 row_ror:4 row_mask:0xf bank_mask:0x8
    s_xor_b32 s59, s58, 4096
    s_waitcnt vmcnt(3)
    buffer_load_dwordx4 v[144:147], v2, s[28:31], s59 offen nt
    v_max3_f32 v8, v28, v29, v30
    v_max_f32 v8, v8, v31
    s_nop 1
    v_max_f32_dpp v8, v8, v8 row_ror:4 row_mask:0xf bank_mask:0xf
    s_nop 1
    v_max_f32_dpp v8, v8, v8 row_ror:8 row_mask:0xf bank_mask:0xf
    v_mov_b32 v18, v8
    s_nop 1
    v_permlane16_swap_b32 v18, v8
    v_max_f32 v8, v8, v18
    v_mov_b32 v18, v8
    s_nop 1
    v_permlane32_swap_b32 v18, v8
    v_max_f32 v8, v8, v18
    v_mul_f32 v8, s46, v8
    v_fma_f32 v28, v28, s46, -v8
    v_fma_f32 v29, v29, s46, -v8
    v_fma_f32 v30, v30, s46, -v8
    v_fma_f32 v31, v31, s46, -v8
    v_exp_f32 v28, v28
    v_exp_f32 v29, v29
    v_exp_f32 v30, v30
    v_exp_f32 v31, v31
    s_nop 0
    v_add_f32 v9, v28, v29
    v_add_f32 v18, v30, v31
    v_add_f32 v9, v9, v18
    s_nop 1
    v_add_f32_dpp v9, v9, v9 row_ror:4 row_mask:0xf bank_mask:0xf
    s_nop 1
    v_add_f32_dpp v9, v9, v9 row_ror:8 row_mask:0xf bank_mask:0xf
    v_mov_b32 v18, v9
    s_nop 1
    v_permlane16_swap_b32 v18, v9
    v_add_f32 v9, v9, v18
    v_mov_b32 v18, v9
    s_nop 1
    v_permlane32_swap_b32 v18, v9
    v_add_f32 v9, v9, v18
    s_mov_b64 exec, 15
    ds_write_b64 v16, v[8:9] offset:40960
    s_mov_b64 exec, 1
    ds_add_u32 v17, v13 offset:42272
    s_mov_b64 exec, -1
    s_xor_b32 s59, s58, 5120
    s_waitcnt vmcnt(3)
    buffer_load_dwordx4 v[148:151], v2, s[28:31], s59 offen nt
    s_mov_b32 s56, 65536
L_w3:
    ds_read_b32 v12, v17 offset:42272
    ds_read_b128 v[192:195], v3 offset:40960
    ds_read_b128 v[196:199], v3 offset:40976
    ds_read_b128 v[200:203], v3 offset:40992
    ds_read_b128 v[204:207], v3 offset:41008
    s_sub_u32 s56, s56, 1
    s_cbranch_scc1 L_w3ok
    s_waitcnt lgkmcnt(0)
    v_cmp_ne_u32 vcc, 8, v12
    s_cbranch_vccnz L_w3
L_w3ok:
    s_waitcnt lgkmcnt(0)
    v_max3_f32 v20, v192, v194, v196
    v_max3_f32 v10, v198, v200, v202
    v_max3_f32 v20, v20, v204, v206
    v_max_f32 v20, v20, v10
    v_sub_f32 v10, v8, v20
    v_exp_f32 v10, v10
    s_cmp_lg_u32 s3, 1
    s_cbranch_scc1 L_nomlpub
    v_sub_f32 v192, v192, v20
    v_sub_f32 v194, v194, v20
    v_sub_f32 v196, v196, v20
    v_sub_f32 v198, v198, v20
    v_sub_f32 v200, v200, v20
    v_sub_f32 v202, v202, v20
    v_sub_f32 v204, v204, v20
    v_sub_f32 v206, v206, v20
    v_exp_f32 v192, v192
    v_exp_f32 v194, v194
    v_exp_f32 v196, v196
    v_exp_f32 v198, v198
    v_exp_f32 v200, v200
    v_exp_f32 v202, v202
    v_exp_f32 v204, v204
    v_exp_f32 v206, v206
    v_mov_b32 v12, v20
    v_mul_f32 v14, v192, v193
    v_fmac_f32 v14, v194, v195
    v_fmac_f32 v14, v196, v197
    v_fmac_f32 v14, v198, v199
    v_fmac_f32 v14, v200, v201
    v_fmac_f32 v14, v202, v203
    v_fmac_f32 v14, v204, v205
    v_fmac_f32 v14, v206, v207
    v_mov_b32 v13, s43
    v_mov_b32 v15, s43
    v_lshlrev_b32 v11, 3, v3
    s_mov_b64 exec, 15
    s_cmp_lg_u32 s42, 0
    s_cbranch_scc1 L_gml
    global_store_dwordx4 v11, v[12:15], s[34:35]
    s_branch L_dml
L_gml:
    global_store_dwordx4 v11, v[12:15], s[34:35] sc1
L_dml:
    s_mov_b64 exec, -1
L_nomlpub:
    v_mul_f32 v28, v10, v28
    v_mul_f32 v29, v10, v29
    v_mul_f32 v30, v10, v30
    v_mul_f32 v31, v10, v31
    v_cvt_pk_bf16_f32 v8, v28, v29
    v_cvt_pk_bf16_f32 v9, v30, v31
    s_xor_b32 s59, s58, 6144
    s_waitcnt vmcnt(3)
    buffer_load_dwordx4 v[152:155], v2, s[28:31], s59 offen nt
    v_and_b32 v4, 7, v0
    v_lshlrev_b32 v4, 10, v4
    v_and_b32 v5, 24, v0
    v_lshl_or_b32 v4, v5, 11, v4
    v_lshrrev_b32 v5, 5, v0
    v_lshl_or_b32 v4, v5, 4, v4
    v_lshlrev_b32 v5, 5, v5
    s_lshl_b32 s47, s7, 17
    s_lshl_b32 s48, s51, 5
    s_add_u32 s47, s47, s48
    s_and_b32 s48, s3, 1
    s_lshl_b32 s48, s48, 13
    s_add_u32 s47, s47, s48
    s_add_u32 s47, s47, 3145728
    s_add_u32 s34, s22, s47
    s_addc_u32 s35, s23, 0
    s_and_b32 s47, s51, 6
    s_lshl_b32 s47, s47, 9
    s_lshl_b32 s48, s7, 7
    s_add_u32 s47, s47, s48
    s_and_b32 s48, s51, 1
    s_lshl_b32 s48, s48, 6
    s_add_u32 s47, s47, s48
    s_and_b32 s48, s51, 0x18
    s_add_u32 s47, s47, s48
    s_add_u32 s36, s18, s47
    s_addc_u32 s37, s19, 0
    v_and_b32 v17, 3, v0
    v_lshlrev_b32 v17, 3, v17
    v_and_b32 v18, 0x3c, v0
    v_lshl_or_b32 v17, v18, 5, v17
    v_add_u32 v17, s50, v17
    v_mov_b32_dpp v32, v8 quad_perm:[0,1,2,3] row_mask:0xf bank_mask:0x1
    v_mov_b32_dpp v33, v8 row_ror:12 row_mask:0xf bank_mask:0x1
    v_mov_b32_dpp v34, v8 row_ror:8 row_mask:0xf bank_mask:0x1
    v_mov_b32_dpp v35, v8 row_ror:4 row_mask:0xf bank_mask:0x1
    v_mov_b32_dpp v36, v8 row_ror:4 row_mask:0xf bank_mask:0x2
    v_mov_b32_dpp v37, v8 quad_perm:[0,1,2,3] row_mask:0xf bank_mask:0x2
    v_mov_b32_dpp v38, v8 row_ror:12 row_mask:0xf bank_mask:0x2
    v_mov_b32_dpp v39, v8 row_ror:8 row_mask:0xf bank_mask:0x2
    v_mov_b32_dpp v40, v8 row_ror:8 row_mask:0xf bank_mask:0x4
    v_mov_b32_dpp v41, v8 row_ror:4 row_mask:0xf bank_mask:0x4
    v_mov_b32_dpp v42, v8 quad_perm:[0,1,2,3] row_mask:0xf bank_mask:0x4
    v_mov_b32_dpp v43, v8 row_ror:12 row_mask:0xf bank_mask:0x4
    v_mov_b32_dpp v44, v8 row_ror:12 row_mask:0xf bank_mask:0x8
    v_mov_b32_dpp v45, v8 row_ror:8 row_mask:0xf bank_mask:0x8
    v_mov_b32_dpp v46, v8 row_ror:4 row_mask:0xf bank_mask:0x8
    v_mov_b32_dpp v47, v8 quad_perm:[0,1,2,3] row_mask:0xf bank_mask:0x8
    v_mov_b32_dpp v48, v9 quad_perm:[0,1,2,3] row_mask:0xf bank_mask:0x1
    v_mov_b32_dpp v49, v9 row_ror:12 row_mask:0xf bank_mask:0x1
    v_mov_b32_dpp v50, v9 row_ror:8 row_mask:0xf bank_mask:0x1
    v_mov_b32_dpp v51, v9 row_ror:4 row_mask:0xf bank_mask:0x1
    v_mov_b32_dpp v52, v9 row_ror:4 row_mask:0xf bank_mask:0x2
    v_mov_b32_dpp v53, v9 quad_perm:[0,1,2,3] row_mask:0xf bank_mask:0x2
    v_mov_b32_dpp v54, v9 row_ror:12 row_mask:0xf bank_mask:0x2
    v_mov_b32_dpp v55, v9 row_ror:8 row_mask:0xf bank_mask:0x2
    v_mov_b32_dpp v56, v9 row_ror:8 row_mask:0xf bank_mask:0x4
    v_mov_b32_dpp v57, v9 row_ror:4 row_mask:0xf bank_mask:0x4
    v_mov_b32_dpp v58, v9 quad_perm:[0,1,2,3] row_mask:0xf bank_mask:0x4
    v_mov_b32_dpp v59, v9 row_ror:12 row_mask:0xf bank_mask:0x4
    v_mov_b32_dpp v60, v9 row_ror:12 row_mask:0xf bank_mask:0x8
    v_mov_b32_dpp v61, v9 row_ror:8 row_mask:0xf bank_mask:0x8
    v_mov_b32_dpp v62, v9 row_ror:4 row_mask:0xf bank_mask:0x8
    v_mov_b32_dpp v63, v9 quad_perm:[0,1,2,3] row_mask:0xf bank_mask:0x8
    s_xor_b32 s59, s58, 7168
    s_waitcnt vmcnt(3)
    buffer_load_dwordx4 v[156:159], v2, s[28:31], s59 offen nt
    v_perm_b32 v64, v132, v128, s44
    v_perm_b32 v68, v132, v128, s45
    v_perm_b32 v72, v133, v129, s44
    v_perm_b32 v76, v133, v129, s45
    v_perm_b32 v80, v134, v130, s44
    v_perm_b32 v84, v134, v130, s45
    v_perm_b32 v88, v135, v131, s44
    v_perm_b32 v92, v135, v131, s45
    v_perm_b32 v65, v140, v136, s44
    v_perm_b32 v69, v140, v136, s45
    v_perm_b32 v73, v141, v137, s44
    v_perm_b32 v77, v141, v137, s45
    v_perm_b32 v81, v142, v138, s44
    v_perm_b32 v85, v142, v138, s45
    v_perm_b32 v89, v143, v139, s44
    v_perm_b32 v93, v143, v139, s45
    s_xor_b32 s59, s58, 8192
    s_waitcnt vmcnt(3)
    buffer_load_dwordx4 v[160:163], v2, s[28:31], s59 offen nt
    s_xor_b32 s59, s58, 9216
    s_waitcnt vmcnt(3)
    buffer_load_dwordx4 v[164:167], v2, s[28:31], s59 offen nt
    v_perm_b32 v66, v148, v144, s44
    v_perm_b32 v70, v148, v144, s45
    v_perm_b32 v74, v149, v145, s44
    v_perm_b32 v78, v149, v145, s45
    v_perm_b32 v82, v150, v146, s44
    v_perm_b32 v86, v150, v146, s45
    v_perm_b32 v90, v151, v147, s44
    v_perm_b32 v94, v151, v147, s45
    s_xor_b32 s59, s58, 10240
    s_waitcnt vmcnt(3)
    buffer_load_dwordx4 v[168:171], v2, s[28:31], s59 offen nt
    global_load_dwordx4 v[220:223], v22, s[60:61] sc1 nt
    global_load_dwordx4 v[224:227], v22, s[60:61] offset:16 sc1 nt
    s_xor_b32 s59, s58, 11264
    s_waitcnt vmcnt(5)
    buffer_load_dwordx4 v[172:175], v2, s[28:31], s59 offen nt
    v_perm_b32 v67, v156, v152, s44
    v_perm_b32 v71, v156, v152, s45
    v_perm_b32 v75, v157, v153, s44
    v_perm_b32 v79, v157, v153, s45
    v_perm_b32 v83, v158, v154, s44
    v_perm_b32 v87, v158, v154, s45
    v_perm_b32 v91, v159, v155, s44
    v_perm_b32 v95, v159, v155, s45
    v_mfma_f32_16x16x32_bf16 v[192:195], v[64:67], v[32:35], 0
    v_mfma_f32_16x16x32_bf16 v[196:199], v[80:83], v[32:35], 0
    v_mfma_f32_16x16x32_bf16 v[192:195], v[68:71], v[36:39], v[192:195]
    v_mfma_f32_16x16x32_bf16 v[196:199], v[84:87], v[36:39], v[196:199]
    v_mfma_f32_16x16x32_bf16 v[192:195], v[72:75], v[40:43], v[192:195]
    v_mfma_f32_16x16x32_bf16 v[196:199], v[88:91], v[40:43], v[196:199]
    v_mfma_f32_16x16x32_bf16 v[192:195], v[76:79], v[44:47], v[192:195]
    v_mfma_f32_16x16x32_bf16 v[196:199], v[92:95], v[44:47], v[196:199]
    s_xor_b32 s59, s58, 12288
    s_waitcnt vmcnt(5)
    buffer_load_dwordx4 v[176:179], v2, s[28:31], s59 offen nt
    s_xor_b32 s59, s58, 13312
    s_waitcnt vmcnt(5)
    buffer_load_dwordx4 v[180:183], v2, s[28:31], s59 offen nt
    v_perm_b32 v96, v164, v160, s44
    v_perm_b32 v100, v164, v160, s45
    v_perm_b32 v104, v165, v161, s44
    v_perm_b32 v108, v165, v161, s45
    v_perm_b32 v112, v166, v162, s44
    v_perm_b32 v116, v166, v162, s45
    v_perm_b32 v120, v167, v163, s44
    v_perm_b32 v124, v167, v163, s45
    s_xor_b32 s59, s58, 14336
    s_waitcnt vmcnt(5)
    buffer_load_dwordx4 v[184:187], v2, s[28:31], s59 offen nt
    s_waitcnt vmcnt(4)
    s_mov_b32 s56, 65536
L_mlchk:
    v_xor_b32 v8, s43, v221
    v_xor_b32 v9, s43, v223
    v_xor_b32 v10, s43, v225
    v_xor_b32 v11, s43, v227
    v_or3_b32 v8, v8, v9, v10
    v_or_b32 v8, v8, v11
    v_cmp_ne_u32 vcc, 0, v8
    s_cbranch_vccz L_mlok
    global_load_dwordx4 v[220:223], v22, s[60:61] sc1 nt
    global_load_dwordx4 v[224:227], v22, s[60:61] offset:16 sc1 nt
    s_sub_u32 s56, s56, 1
    s_waitcnt vmcnt(0)
    s_cbranch_scc0 L_mlchk
L_mlok:
    v_max_f32 v8, v220, v224
    v_mov_b32 v9, v8
    s_nop 1
    v_permlane16_swap_b32 v9, v8
    v_max_f32 v8, v8, v9
    v_mov_b32 v9, v8
    s_nop 1
    v_permlane32_swap_b32 v9, v8
    v_max_f32 v8, v8, v9
    v_sub_f32 v14, v220, v8
    v_sub_f32 v15, v224, v8
    v_exp_f32 v14, v14
    v_exp_f32 v15, v15
    s_nop 0
    v_mul_f32 v11, v14, v222
    v_fmac_f32 v11, v15, v226
    v_mov_b32 v9, v11
    s_nop 1
    v_permlane16_swap_b32 v9, v11
    v_add_f32 v11, v11, v9
    v_mov_b32 v9, v11
    s_nop 1
    v_permlane32_swap_b32 v9, v11
    v_add_f32 v11, v11, v9
    v_rcp_f32 v11, v11
    s_nop 0
    v_mul_f32 v14, v11, v14
    v_mul_f32 v15, v11, v15
    s_xor_b32 s59, s58, 15360
    s_waitcnt vmcnt(3)
    buffer_load_dwordx4 v[188:191], v2, s[28:31], s59 offen nt
    v_perm_b32 v97, v172, v168, s44
    v_perm_b32 v101, v172, v168, s45
    v_perm_b32 v105, v173, v169, s44
    v_perm_b32 v109, v173, v169, s45
    v_perm_b32 v113, v174, v170, s44
    v_perm_b32 v117, v174, v170, s45
    v_perm_b32 v121, v175, v171, s44
    v_perm_b32 v125, v175, v171, s45
    s_waitcnt vmcnt(2)
    v_perm_b32 v98, v180, v176, s44
    v_perm_b32 v102, v180, v176, s45
    v_perm_b32 v106, v181, v177, s44
    v_perm_b32 v110, v181, v177, s45
    v_perm_b32 v114, v182, v178, s44
    v_perm_b32 v118, v182, v178, s45
    v_perm_b32 v122, v183, v179, s44
    v_perm_b32 v126, v183, v179, s45
    s_add_u32 m0, s50, 16384
    s_nop 0
    s_waitcnt vmcnt(1)
    global_load_lds_dwordx4 v6, s[38:39] nt
    global_load_lds_dwordx4 v6, s[52:53] offset:1024 nt
    s_waitcnt vmcnt(2)
    v_perm_b32 v99, v188, v184, s44
    v_perm_b32 v103, v188, v184, s45
    v_perm_b32 v107, v189, v185, s44
    v_perm_b32 v111, v189, v185, s45
    v_perm_b32 v115, v190, v186, s44
    v_perm_b32 v119, v190, v186, s45
    v_perm_b32 v123, v191, v187, s44
    v_perm_b32 v127, v191, v187, s45
    v_mfma_f32_16x16x32_bf16 v[192:195], v[96:99], v[48:51], v[192:195]
    v_mfma_f32_16x16x32_bf16 v[196:199], v[112:115], v[48:51], v[196:199]
    v_mfma_f32_16x16x32_bf16 v[192:195], v[100:103], v[52:55], v[192:195]
    v_mfma_f32_16x16x32_bf16 v[196:199], v[116:119], v[52:55], v[196:199]
    v_mfma_f32_16x16x32_bf16 v[192:195], v[104:107], v[56:59], v[192:195]
    v_mfma_f32_16x16x32_bf16 v[196:199], v[120:123], v[56:59], v[196:199]
    v_mfma_f32_16x16x32_bf16 v[192:195], v[108:111], v[60:63], v[192:195]
    v_mfma_f32_16x16x32_bf16 v[196:199], v[124:127], v[60:63], v[196:199]
    s_nop 6
    ds_write_b128 v19, v[192:195] offset:0
    ds_write_b128 v19, v[196:199] offset:1024
    s_lshr_b32 s47, s3, 1
    s_cmp_lg_u32 s47, 2
    s_cbranch_scc1 L_noeh
    s_xor_b32 s47, s51, 4
    s_lshl_b32 s47, s47, 7
    s_lshl_b32 s48, s51, 5
    s_sub_u32 s47, s47, s48
    s_add_u32 s47, s47, 0x10000
    v_mov_b32 v10, s47
    v_and_b32 v10, 3, v0
    v_lshlrev_b32 v10, v10, 4
    v_min_u32 v10, 28, v10
    v_xor_b32 v10, s51, v10
    s_sub_u32 s47, 0x10000, s48
    v_lshl_add_u32 v10, v10, 7, s47
    global_load_dword v140, v10, s[34:35] sc1
L_noeh:
    s_lshl_b32 s47, s3, 8
    v_lshl_add_u32 v10, v0, 2, s47
    v_mov_b32 v8, s41
    s_waitcnt lgkmcnt(0)
    s_barrier
    ds_read2st64_b32 v[64:65], v10 offset0:0 offset1:8
    ds_read2st64_b32 v[66:67], v10 offset0:16 offset1:24
    ds_read2st64_b32 v[68:69], v10 offset0:32 offset1:40
    ds_read2st64_b32 v[70:71], v10 offset0:48 offset1:56
    s_waitcnt lgkmcnt(2)
    v_add_f32 v64, v64, v65
    v_add_f32 v66, v66, v67
    s_waitcnt lgkmcnt(0)
    v_add_f32 v68, v68, v69
    v_add_f32 v70, v70, v71
    v_add_f32 v64, v64, v66
    v_add_f32 v68, v68, v70
    v_add_f32 v64, v64, v68
    v_and_or_b32 v64, v64, s57, v8
    s_cmp_lg_u32 s42, 0
    s_cbranch_scc1 L_go
    global_store_dword v23, v64, s[32:33]
    s_branch L_do
L_go:
    global_store_dword v23, v64, s[32:33] sc1
L_do:
    global_load_dwordx4 v[228:231], v21, s[62:63] sc1
    global_load_dwordx4 v[232:235], v21, s[62:63] offset:2048 sc1
    s_cmp_lg_u32 s3, 5
    s_cbranch_scc1 L_nosw
    s_load_dword s90, s[34:35], 0x18000
L_nosw:
    s_mov_b32 s24, 0x11111111
    s_mov_b32 s25, 0x11111111
    s_mov_b32 s26, 0x22222222
    s_mov_b32 s27, 0x22222222
    s_mov_b32 s28, 0x44444444
    s_mov_b32 s29, 0x44444444
    s_mov_b32 s30, 0x88888888
    s_mov_b32 s31, 0x88888888
    s_mov_b32 s56, 65536
    s_waitcnt vmcnt(0)
    ds_read_b64_tr_b16 v[200:201], v17 offset:16384
    ds_read_b64_tr_b16 v[202:203], v17 offset:16416
    ds_read_b64_tr_b16 v[204:205], v17 offset:16448
    ds_read_b64_tr_b16 v[206:207], v17 offset:16480
L_h1:
    v_xor_b32 v96, s41, v228
    v_xor_b32 v97, s41, v229
    v_xor_b32 v98, s41, v230
    v_xor_b32 v99, s41, v231
    v_xor_b32 v100, s41, v232
    v_xor_b32 v101, s41, v233
    v_xor_b32 v102, s41, v234
    v_xor_b32 v103, s41, v235
    v_or3_b32 v9, v96, v97, v98
    v_or3_b32 v11, v100, v101, v102
    v_or_b32 v9, v9, v99
    v_or_b32 v11, v11, v103
    v_cmp_ne_u32_sdwa s[48:49], v9, 0 src0_sel:BYTE_0 src1_sel:DWORD
    v_cmp_ne_u32_sdwa vcc, v11, 0 src0_sel:BYTE_0 src1_sel:DWORD
    s_or_b64 s[38:39], s[48:49], vcc
    s_cbranch_scc0 L_h1ok
    s_mov_b64 exec, s[48:49]
    global_load_dwordx4 v[228:231], v21, s[62:63] sc1
    s_mov_b64 exec, vcc
    global_load_dwordx4 v[232:235], v21, s[62:63] offset:2048 sc1
    s_mov_b64 exec, -1
    s_sub_u32 s56, s56, 1
    s_waitcnt vmcnt(0)
    s_cbranch_scc0 L_h1
L_h1ok:
    v_pk_mul_f32 v[96:97], v[14:15], v[96:97] op_sel_hi:[0,1]
    v_pk_mul_f32 v[98:99], v[14:15], v[98:99] op_sel_hi:[0,1]
    v_pk_fma_f32 v[96:97], v[14:15], v[100:101], v[96:97] op_sel:[1,0,0] op_sel_hi:[1,1,1]
    v_pk_fma_f32 v[98:99], v[14:15], v[102:103], v[98:99] op_sel:[1,0,0] op_sel_hi:[1,1,1]
    s_nop 0
    s_lshl_b32 s47, s3, 10
    v_permlane32_swap_b32 v96, v98
    v_permlane32_swap_b32 v97, v99
    v_add_f32 v96, v96, v98
    v_add_f32 v97, v97, v99
    v_add_u32 v3, s47, v2
    s_nop 0
    v_permlane16_swap_b32 v96, v97
    v_add_f32 v96, v96, v97
    s_nop 1
    v_mov_b32_dpp v100, v96 quad_perm:[0,0,0,0] row_mask:0xf bank_mask:0xf
    v_mov_b32_dpp v101, v96 quad_perm:[1,1,1,1] row_mask:0xf bank_mask:0xf
    v_mov_b32_dpp v102, v96 quad_perm:[2,2,2,2] row_mask:0xf bank_mask:0xf
    v_mov_b32_dpp v103, v96 quad_perm:[3,3,3,3] row_mask:0xf bank_mask:0xf
    v_cvt_pk_bf16_f32 v12, v100, v101
    v_cvt_pk_bf16_f32 v13, v102, v103
    v_cndmask_b32 v208, 0, v12, s[24:25]
    v_cndmask_b32 v209, 0, v13, s[24:25]
    v_cndmask_b32 v210, 0, v12, s[26:27]
    v_cndmask_b32 v211, 0, v13, s[26:27]
    v_cndmask_b32 v212, 0, v12, s[28:29]
    v_cndmask_b32 v213, 0, v13, s[28:29]
    v_cndmask_b32 v214, 0, v12, s[30:31]
    v_cndmask_b32 v215, 0, v13, s[30:31]
    s_waitcnt lgkmcnt(0)
    v_mfma_f32_16x16x32_bf16 v[216:219], v[200:203], v[208:211], 0
    v_mfma_f32_16x16x32_bf16 v[216:219], v[204:207], v[212:215], v[216:219]
    s_lshl_b32 s47, s7, 17
    s_and_b32 s48, s51, 7
    s_lshl_b32 s48, s48, 10
    s_add_u32 s47, s47, s48
    s_and_b32 s48, s51, 24
    s_lshl_b32 s48, s48, 11
    s_add_u32 s47, s47, s48
    s_add_u32 s47, s47, 3145728
    s_add_u32 s32, s22, s47
    s_addc_u32 s33, s23, 0
    s_nop 1
    ds_write_b128 v3, v[216:219] offset:32768
    s_mul_i32 s47, s51, 96
    s_add_u32 s47, s47, 0x10000
    s_mov_b32 s91, s47
    v_mov_b32 v14, s47
    s_lshr_b32 s47, s3, 1
    v_mov_b32 v12, 0
    v_mov_b32 v13, 1
    s_cmp_eq_u32 s47, 2
    s_waitcnt lgkmcnt(0)
    s_barrier
    s_cbranch_scc1 L_final
    s_cmp_gt_u32 s3, 0
    s_cbranch_scc1 L_fin
    ds_read_b128 v[64:67], v2 offset:32768
    ds_read_b128 v[68:71], v2 offset:33792
    ds_read_b128 v[72:75], v2 offset:34816
    ds_read_b128 v[76:79], v2 offset:35840
    ds_read_b128 v[80:83], v2 offset:36864
    ds_read_b128 v[84:87], v2 offset:37888
    ds_read_b128 v[88:91], v2 offset:38912
    ds_read_b128 v[92:95], v2 offset:39936
    v_add_u32 v10, 0x2000, v2
    s_waitcnt lgkmcnt(6)
    v_pk_add_f32 v[64:65], v[64:65], v[68:69]
    v_pk_add_f32 v[66:67], v[66:67], v[70:71]
    s_waitcnt lgkmcnt(4)
    v_pk_add_f32 v[72:73], v[72:73], v[76:77]
    v_pk_add_f32 v[74:75], v[74:75], v[78:79]
    s_waitcnt lgkmcnt(2)
    v_pk_add_f32 v[80:81], v[80:81], v[84:85]
    v_pk_add_f32 v[82:83], v[82:83], v[86:87]
    v_pk_add_f32 v[64:65], v[64:65], v[72:73]
    v_pk_add_f32 v[66:67], v[66:67], v[74:75]
    s_waitcnt lgkmcnt(0)
    v_pk_add_f32 v[88:89], v[88:89], v[92:93]
    v_pk_add_f32 v[90:91], v[90:91], v[94:95]
    v_pk_add_f32 v[64:65], v[64:65], v[80:81]
    v_pk_add_f32 v[66:67], v[66:67], v[82:83]
    v_pk_add_f32 v[64:65], v[64:65], v[88:89]
    v_pk_add_f32 v[66:67], v[66:67], v[90:91]
    v_and_or_b32 v64, v64, s57, v8
    v_and_or_b32 v65, v65, s57, v8
    v_and_or_b32 v66, v66, s57, v8
    v_and_or_b32 v67, v67, s57, v8
    global_store_dwordx4 v2, v[64:67], s[32:33] sc1
    global_store_dwordx4 v10, v[64:67], s[32:33] sc1
    s_branch L_fin
L_final:
    s_mov_b32 s56, 65536
    s_and_b32 s47, s3, 1
    s_cbranch_scc1 L_sprobe
    global_load_dword v15, v14, s[34:35] sc1
    s_branch L_claim
L_sprobe:
    s_load_dword s90, s[34:35], s91
    s_waitcnt lgkmcnt(0)
L_claim:
    s_waitcnt vmcnt(0)
    s_mov_b64 exec, 1
    ds_add_rtn_u32 v11, v12, v13 offset:42304
    s_mov_b64 exec, -1
    s_waitcnt lgkmcnt(0)
    v_readfirstlane_b32 s47, v11
    s_cmp_lg_u32 s47, 0
    s_cbranch_scc1 L_fin
    global_load_dwordx4 v[136:139], v4, s[34:35] sc1
    global_load_dwordx4 v[140:143], v4, s[34:35] sc1
L_h2:
    s_waitcnt vmcnt(1)
    v_xor_b32 v96, s41, v136
    v_xor_b32 v97, s41, v137
    v_xor_b32 v98, s41, v138
    v_xor_b32 v99, s41, v139
    v_or3_b32 v10, v96, v97, v98
    v_or_b32 v10, v10, v99
    v_cmpx_ne_u32_sdwa vcc, v10, 0 src0_sel:BYTE_0 src1_sel:DWORD
    s_cbranch_execz L_h2ok
    global_load_dwordx4 v[136:139], v4, s[34:35] sc1
    s_waitcnt vmcnt(1)
    v_xor_b32 v96, s41, v140
    v_xor_b32 v97, s41, v141
    v_xor_b32 v98, s41, v142
    v_xor_b32 v99, s41, v143
    v_or3_b32 v10, v96, v97, v98
    v_or_b32 v10, v10, v99
    v_cmpx_ne_u32_sdwa vcc, v10, 0 src0_sel:BYTE_0 src1_sel:DWORD
    s_cbranch_execz L_h2ok
    global_load_dwordx4 v[140:143], v4, s[34:35] sc1
    s_sub_u32 s56, s56, 1
    s_cbranch_scc0 L_h2
L_h2ok:
    s_mov_b64 exec, -1
    s_nop 2
    v_add_f32_dpp v96, v96, v96 quad_perm:[1,0,3,2] row_mask:0xf bank_mask:0xf
    v_add_f32_dpp v97, v97, v97 quad_perm:[1,0,3,2] row_mask:0xf bank_mask:0xf
    v_add_f32_dpp v98, v98, v98 quad_perm:[1,0,3,2] row_mask:0xf bank_mask:0xf
    v_add_f32_dpp v99, v99, v99 quad_perm:[1,0,3,2] row_mask:0xf bank_mask:0xf
    v_add_f32_dpp v96, v96, v96 quad_perm:[2,3,0,1] row_mask:0xf bank_mask:0xf
    v_add_f32_dpp v97, v97, v97 quad_perm:[2,3,0,1] row_mask:0xf bank_mask:0xf
    v_add_f32_dpp v98, v98, v98 quad_perm:[2,3,0,1] row_mask:0xf bank_mask:0xf
    v_add_f32_dpp v99, v99, v99 quad_perm:[2,3,0,1] row_mask:0xf bank_mask:0xf
    v_add_f32_dpp v96, v96, v96 row_ror:4 row_mask:0xf bank_mask:0xf
    v_add_f32_dpp v97, v97, v97 row_ror:4 row_mask:0xf bank_mask:0xf
    v_add_f32_dpp v98, v98, v98 row_ror:4 row_mask:0xf bank_mask:0xf
    v_add_f32_dpp v99, v99, v99 row_ror:4 row_mask:0xf bank_mask:0xf
    v_add_f32_dpp v96, v96, v96 row_ror:8 row_mask:0xf bank_mask:0xf
    v_add_f32_dpp v97, v97, v97 row_ror:8 row_mask:0xf bank_mask:0xf
    v_add_f32_dpp v98, v98, v98 row_ror:8 row_mask:0xf bank_mask:0xf
    v_add_f32_dpp v99, v99, v99 row_ror:8 row_mask:0xf bank_mask:0xf
    v_add_f32_dpp v96, v96, v96 row_bcast:15 row_mask:0xa bank_mask:0xf
    v_add_f32_dpp v97, v97, v97 row_bcast:15 row_mask:0xa bank_mask:0xf
    v_add_f32_dpp v98, v98, v98 row_bcast:15 row_mask:0xa bank_mask:0xf
    v_add_f32_dpp v99, v99, v99 row_bcast:15 row_mask:0xa bank_mask:0xf
    v_cvt_pk_bf16_f32 v96, v96, v97
    v_cvt_pk_bf16_f32 v97, v98, v99
    s_mov_b32 exec_lo, 0x80000000
    s_mov_b32 exec_hi, 0x80000000
    global_store_dwordx2 v5, v[96:97], s[36:37]
    s_cmp_lg_u32 s2, 0
    s_cbranch_scc1 L_fin
    s_mov_b64 exec, 1
    v_mov_b32 v8, 0
    v_mov_b32 v9, s43
    global_store_dword v8, v9, s[22:23]
L_fin:
    s_waitcnt vmcnt(0)
L_end:
    s_endpgm
L_qretry:
    s_and_b32 s47, s56, 7
    s_cmp_lg_u32 s47, 1
    s_cbranch_scc1 L_qr1
    ds_read_b32 v12, v30 offset:42288
    ds_read_b128 v[192:195], v2 offset:32768
    v_and_b32 v13, 12, v0
    v_lshlrev_b32 v13, 11, v13
    v_and_b32 v14, 0x30, v0
    v_or_b32 v13, v13, v14
    v_and_b32 v14, 3, v0
    v_lshl_or_b32 v13, v14, 6, v13
    s_waitcnt lgkmcnt(0)
    v_cmp_ne_u32 vcc, 0, v12
    s_cbranch_vccz L_qr1
    global_store_dwordx4 v13, v[192:195], s[36:37] sc1
L_qr1:
    global_load_dwordx4 v[8:11], v7, s[54:55] sc1 nt
    s_sub_u32 s56, s56, 1
    s_waitcnt vmcnt(0)
    s_cbranch_scc0 L_qchk
    s_branch L_qok
L_rep2:
    s_cmp_lg_u32 s3, 0
    s_cbranch_scc1 L_rep2ret
    ds_read_b128 v[192:195], v2 offset:32768
    v_and_b32 v13, 12, v0
    v_lshlrev_b32 v13, 11, v13
    v_and_b32 v14, 0x30, v0
    v_or_b32 v13, v13, v14
    v_and_b32 v14, 3, v0
    v_lshl_or_b32 v13, v14, 6, v13
    s_waitcnt lgkmcnt(0)
    global_store_dwordx4 v13, v[192:195], s[36:37] sc1
    s_nop 4
    s_branch L_rep2ret
    s_endpgm
.section .rodata,"a"
.p2align 6
.amdhsa_kernel standalone__sliding_block_cached__decode_kernel
  .amdhsa_next_free_vgpr 256
  .amdhsa_next_free_sgpr 96
  .amdhsa_accum_offset 256
  .amdhsa_group_segment_fixed_size 0
  .amdhsa_kernarg_size 64
  .amdhsa_user_sgpr_count 2
  .amdhsa_user_sgpr_kernarg_segment_ptr 1
  .amdhsa_system_sgpr_workgroup_id_x 1
.end_amdhsa_kernel
```
